```python
import torch

def _softmax(x, axis=-1):
    return torch.softmax(x, dim=axis)
def _gelu(x):
    return torch.nn.functional.gelu(x, approximate="tanh")
def _silu(x):
    return torch.nn.functional.silu(x)
def _sigmoid(x):
    return torch.sigmoid(x)
def _layernorm(x, axis=-1, eps=1e-5):
    m = x.mean(dim=axis, keepdim=True)
    v = x.var(dim=axis, keepdim=True, unbiased=False)
    return (x - m) / torch.sqrt(v + eps)
def _scatter_add(tgt, idx, src, axis=0):
    return tgt.clone().index_add_(axis, idx, src)
def _segment_sum(src, seg, n):
    out = torch.zeros((n,) + src.shape[1:], dtype=src.dtype)
    return out.index_add_(0, seg, src)
def _pad(x, pw):
    flat = tuple(v for pair in reversed(pw) for v in pair)
    return torch.nn.functional.pad(x, flat)

kernel_name = 'standalone__rezero__sampling'

def setup_inputs():

    _w = (lambda a: (lambda t: t.to(torch.bfloat16) if t.is_floating_point() else t)(torch.as_tensor(a)))
    B, S, D = 512, 32, 640
    return {
        "x": _w((lambda *s: torch.randn(*s, dtype=torch.bfloat16) * 0.05)(B, S, D)),
        "fx": _w((lambda *s: torch.randn(*s, dtype=torch.bfloat16) * 0.8)(B, S, D)),
        "alpha": _w((lambda *s: torch.randn(*s, dtype=torch.bfloat16) * 0.8)(1) * 0.1),
    }

def reference(x, fx, alpha):
    return x + alpha * fx
```

```asm
; @launch grid=(256,1,1) block=(512,1,1) lds=0
.amdgcn_target "amdgcn-amd-amdhsa--gfx950"
.text
.globl standalone__rezero__sampling_kernel
.p2align 8
.type standalone__rezero__sampling_kernel,@function
standalone__rezero__sampling_kernel:
    s_load_dwordx2 s[12:13], s[0:1], 0
    s_load_dwordx2 s[16:17], s[0:1], 8
    s_load_dwordx2 s[20:21], s[0:1], 24
    s_load_dwordx2 s[8:9], s[0:1], 16
    s_cmpk_ge_u32 s2, 256
    s_cbranch_scc1 L_done
    s_lshl_b32 s3, s2, 13
    v_lshlrev_b32 v0, 4, v0
    s_mov_b32 s14, 20971520
    s_mov_b32 s15, 0x20000
    s_mov_b64 s[18:19], s[14:15]
    s_mov_b64 s[22:23], s[14:15]
    s_add_u32 s33, s3, 2097152
    s_add_u32 s34, s3, 4194304
    s_waitcnt lgkmcnt(0)
    buffer_load_dwordx4 v[4:7], v0, s[12:15], s3 offen nt
    buffer_load_dwordx4 v[8:11], v0, s[16:19], s3 offen nt
    buffer_load_dwordx4 v[12:15], v0, s[12:15], s33 offen nt
    buffer_load_dwordx4 v[16:19], v0, s[16:19], s33 offen nt
    s_load_dword s8, s[8:9], 0
    s_add_u32 s35, s3, 6291456
    s_add_u32 s36, s3, 8388608
    s_add_u32 s37, s3, 10485760
    s_add_u32 s38, s3, 12582912
    s_add_u32 s39, s3, 14680064
    s_add_u32 s40, s3, 16777216
    s_add_u32 s41, s3, 18874368
    s_mov_b32 s10, 0xffff0000
    s_waitcnt lgkmcnt(0)
    s_lshl_b32 s8, s8, 16
    s_mov_b32 s9, s8
    s_waitcnt vmcnt(2)
    buffer_load_dwordx4 v[20:23], v0, s[12:15], s34 offen nt
    buffer_load_dwordx4 v[24:27], v0, s[16:19], s34 offen nt
    v_lshlrev_b32 v28, 16, v8
    v_and_b32 v29, s10, v8
    v_lshlrev_b32 v30, 16, v9
    v_and_b32 v31, s10, v9
    v_lshlrev_b32 v32, 16, v10
    v_and_b32 v33, s10, v10
    v_lshlrev_b32 v34, 16, v11
    v_and_b32 v35, s10, v11
    v_pk_mul_f32 v[28:29], v[28:29], s[8:9]
    v_pk_mul_f32 v[30:31], v[30:31], s[8:9]
    v_pk_mul_f32 v[32:33], v[32:33], s[8:9]
    v_pk_mul_f32 v[34:35], v[34:35], s[8:9]
    v_lshlrev_b32 v36, 16, v4
    v_and_b32 v37, s10, v4
    v_lshlrev_b32 v38, 16, v5
    v_and_b32 v39, s10, v5
    v_lshlrev_b32 v40, 16, v6
    v_and_b32 v41, s10, v6
    v_lshlrev_b32 v42, 16, v7
    v_and_b32 v43, s10, v7
    v_cvt_pk_bf16_f32 v8, v28, v29
    v_cvt_pk_bf16_f32 v9, v30, v31
    v_cvt_pk_bf16_f32 v10, v32, v33
    v_cvt_pk_bf16_f32 v11, v34, v35
    v_lshlrev_b32 v28, 16, v8
    v_and_b32 v29, s10, v8
    v_lshlrev_b32 v30, 16, v9
    v_and_b32 v31, s10, v9
    v_lshlrev_b32 v32, 16, v10
    v_and_b32 v33, s10, v10
    v_lshlrev_b32 v34, 16, v11
    v_and_b32 v35, s10, v11
    v_pk_add_f32 v[36:37], v[36:37], v[28:29]
    v_pk_add_f32 v[38:39], v[38:39], v[30:31]
    v_pk_add_f32 v[40:41], v[40:41], v[32:33]
    v_pk_add_f32 v[42:43], v[42:43], v[34:35]
    v_cvt_pk_bf16_f32 v4, v36, v37
    v_cvt_pk_bf16_f32 v5, v38, v39
    v_cvt_pk_bf16_f32 v6, v40, v41
    v_cvt_pk_bf16_f32 v7, v42, v43
    buffer_store_dwordx4 v[4:7], v0, s[20:23], s3 offen sc1
    s_waitcnt vmcnt(3)
    buffer_load_dwordx4 v[4:7], v0, s[12:15], s35 offen nt
    buffer_load_dwordx4 v[8:11], v0, s[16:19], s35 offen nt
    v_lshlrev_b32 v28, 16, v16
    v_and_b32 v29, s10, v16
    v_lshlrev_b32 v30, 16, v17
    v_and_b32 v31, s10, v17
    v_lshlrev_b32 v32, 16, v18
    v_and_b32 v33, s10, v18
    v_lshlrev_b32 v34, 16, v19
    v_and_b32 v35, s10, v19
    v_pk_mul_f32 v[28:29], v[28:29], s[8:9]
    v_pk_mul_f32 v[30:31], v[30:31], s[8:9]
    v_pk_mul_f32 v[32:33], v[32:33], s[8:9]
    v_pk_mul_f32 v[34:35], v[34:35], s[8:9]
    v_lshlrev_b32 v36, 16, v12
    v_and_b32 v37, s10, v12
    v_lshlrev_b32 v38, 16, v13
    v_and_b32 v39, s10, v13
    v_lshlrev_b32 v40, 16, v14
    v_and_b32 v41, s10, v14
    v_lshlrev_b32 v42, 16, v15
    v_and_b32 v43, s10, v15
    v_cvt_pk_bf16_f32 v16, v28, v29
    v_cvt_pk_bf16_f32 v17, v30, v31
    v_cvt_pk_bf16_f32 v18, v32, v33
    v_cvt_pk_bf16_f32 v19, v34, v35
    v_lshlrev_b32 v28, 16, v16
    v_and_b32 v29, s10, v16
    v_lshlrev_b32 v30, 16, v17
    v_and_b32 v31, s10, v17
    v_lshlrev_b32 v32, 16, v18
    v_and_b32 v33, s10, v18
    v_lshlrev_b32 v34, 16, v19
    v_and_b32 v35, s10, v19
    v_pk_add_f32 v[36:37], v[36:37], v[28:29]
    v_pk_add_f32 v[38:39], v[38:39], v[30:31]
    v_pk_add_f32 v[40:41], v[40:41], v[32:33]
    v_pk_add_f32 v[42:43], v[42:43], v[34:35]
    v_cvt_pk_bf16_f32 v12, v36, v37
    v_cvt_pk_bf16_f32 v13, v38, v39
    v_cvt_pk_bf16_f32 v14, v40, v41
    v_cvt_pk_bf16_f32 v15, v42, v43
    buffer_store_dwordx4 v[12:15], v0, s[20:23], s33 offen sc1
    s_waitcnt vmcnt(4)
    buffer_load_dwordx4 v[12:15], v0, s[12:15], s36 offen nt
    buffer_load_dwordx4 v[16:19], v0, s[16:19], s36 offen nt
    v_lshlrev_b32 v28, 16, v24
    v_and_b32 v29, s10, v24
    v_lshlrev_b32 v30, 16, v25
    v_and_b32 v31, s10, v25
    v_lshlrev_b32 v32, 16, v26
    v_and_b32 v33, s10, v26
    v_lshlrev_b32 v34, 16, v27
    v_and_b32 v35, s10, v27
    v_pk_mul_f32 v[28:29], v[28:29], s[8:9]
    v_pk_mul_f32 v[30:31], v[30:31], s[8:9]
    v_pk_mul_f32 v[32:33], v[32:33], s[8:9]
    v_pk_mul_f32 v[34:35], v[34:35], s[8:9]
    v_lshlrev_b32 v36, 16, v20
    v_and_b32 v37, s10, v20
    v_lshlrev_b32 v38, 16, v21
    v_and_b32 v39, s10, v21
    v_lshlrev_b32 v40, 16, v22
    v_and_b32 v41, s10, v22
    v_lshlrev_b32 v42, 16, v23
    v_and_b32 v43, s10, v23
    v_cvt_pk_bf16_f32 v24, v28, v29
    v_cvt_pk_bf16_f32 v25, v30, v31
    v_cvt_pk_bf16_f32 v26, v32, v33
    v_cvt_pk_bf16_f32 v27, v34, v35
    v_lshlrev_b32 v28, 16, v24
    v_and_b32 v29, s10, v24
    v_lshlrev_b32 v30, 16, v25
    v_and_b32 v31, s10, v25
    v_lshlrev_b32 v32, 16, v26
    v_and_b32 v33, s10, v26
    v_lshlrev_b32 v34, 16, v27
    v_and_b32 v35, s10, v27
    v_pk_add_f32 v[36:37], v[36:37], v[28:29]
    v_pk_add_f32 v[38:39], v[38:39], v[30:31]
    v_pk_add_f32 v[40:41], v[40:41], v[32:33]
    v_pk_add_f32 v[42:43], v[42:43], v[34:35]
    v_cvt_pk_bf16_f32 v20, v36, v37
    v_cvt_pk_bf16_f32 v21, v38, v39
    v_cvt_pk_bf16_f32 v22, v40, v41
    v_cvt_pk_bf16_f32 v23, v42, v43
    buffer_store_dwordx4 v[20:23], v0, s[20:23], s34 offen sc1
    s_waitcnt vmcnt(4)
    buffer_load_dwordx4 v[20:23], v0, s[12:15], s37 offen nt
    buffer_load_dwordx4 v[24:27], v0, s[16:19], s37 offen nt
    v_lshlrev_b32 v28, 16, v8
    v_and_b32 v29, s10, v8
    v_lshlrev_b32 v30, 16, v9
    v_and_b32 v31, s10, v9
    v_lshlrev_b32 v32, 16, v10
    v_and_b32 v33, s10, v10
    v_lshlrev_b32 v34, 16, v11
    v_and_b32 v35, s10, v11
    v_pk_mul_f32 v[28:29], v[28:29], s[8:9]
    v_pk_mul_f32 v[30:31], v[30:31], s[8:9]
    v_pk_mul_f32 v[32:33], v[32:33], s[8:9]
    v_pk_mul_f32 v[34:35], v[34:35], s[8:9]
    v_lshlrev_b32 v36, 16, v4
    v_and_b32 v37, s10, v4
    v_lshlrev_b32 v38, 16, v5
    v_and_b32 v39, s10, v5
    v_lshlrev_b32 v40, 16, v6
    v_and_b32 v41, s10, v6
    v_lshlrev_b32 v42, 16, v7
    v_and_b32 v43, s10, v7
    v_cvt_pk_bf16_f32 v8, v28, v29
    v_cvt_pk_bf16_f32 v9, v30, v31
    v_cvt_pk_bf16_f32 v10, v32, v33
    v_cvt_pk_bf16_f32 v11, v34, v35
    v_lshlrev_b32 v28, 16, v8
    v_and_b32 v29, s10, v8
    v_lshlrev_b32 v30, 16, v9
    v_and_b32 v31, s10, v9
    v_lshlrev_b32 v32, 16, v10
    v_and_b32 v33, s10, v10
    v_lshlrev_b32 v34, 16, v11
    v_and_b32 v35, s10, v11
    v_pk_add_f32 v[36:37], v[36:37], v[28:29]
    v_pk_add_f32 v[38:39], v[38:39], v[30:31]
    v_pk_add_f32 v[40:41], v[40:41], v[32:33]
    v_pk_add_f32 v[42:43], v[42:43], v[34:35]
    v_cvt_pk_bf16_f32 v4, v36, v37
    v_cvt_pk_bf16_f32 v5, v38, v39
    v_cvt_pk_bf16_f32 v6, v40, v41
    v_cvt_pk_bf16_f32 v7, v42, v43
    buffer_store_dwordx4 v[4:7], v0, s[20:23], s35 offen sc1
    s_waitcnt vmcnt(4)
    buffer_load_dwordx4 v[4:7], v0, s[12:15], s38 offen nt
    buffer_load_dwordx4 v[8:11], v0, s[16:19], s38 offen nt
    v_lshlrev_b32 v28, 16, v16
    v_and_b32 v29, s10, v16
    v_lshlrev_b32 v30, 16, v17
    v_and_b32 v31, s10, v17
    v_lshlrev_b32 v32, 16, v18
    v_and_b32 v33, s10, v18
    v_lshlrev_b32 v34, 16, v19
    v_and_b32 v35, s10, v19
    v_pk_mul_f32 v[28:29], v[28:29], s[8:9]
    v_pk_mul_f32 v[30:31], v[30:31], s[8:9]
    v_pk_mul_f32 v[32:33], v[32:33], s[8:9]
    v_pk_mul_f32 v[34:35], v[34:35], s[8:9]
    v_lshlrev_b32 v36, 16, v12
    v_and_b32 v37, s10, v12
    v_lshlrev_b32 v38, 16, v13
    v_and_b32 v39, s10, v13
    v_lshlrev_b32 v40, 16, v14
    v_and_b32 v41, s10, v14
    v_lshlrev_b32 v42, 16, v15
    v_and_b32 v43, s10, v15
    v_cvt_pk_bf16_f32 v16, v28, v29
    v_cvt_pk_bf16_f32 v17, v30, v31
    v_cvt_pk_bf16_f32 v18, v32, v33
    v_cvt_pk_bf16_f32 v19, v34, v35
    v_lshlrev_b32 v28, 16, v16
    v_and_b32 v29, s10, v16
    v_lshlrev_b32 v30, 16, v17
    v_and_b32 v31, s10, v17
    v_lshlrev_b32 v32, 16, v18
    v_and_b32 v33, s10, v18
    v_lshlrev_b32 v34, 16, v19
    v_and_b32 v35, s10, v19
    v_pk_add_f32 v[36:37], v[36:37], v[28:29]
    v_pk_add_f32 v[38:39], v[38:39], v[30:31]
    v_pk_add_f32 v[40:41], v[40:41], v[32:33]
    v_pk_add_f32 v[42:43], v[42:43], v[34:35]
    v_cvt_pk_bf16_f32 v12, v36, v37
    v_cvt_pk_bf16_f32 v13, v38, v39
    v_cvt_pk_bf16_f32 v14, v40, v41
    v_cvt_pk_bf16_f32 v15, v42, v43
    buffer_store_dwordx4 v[12:15], v0, s[20:23], s36 offen sc1
    s_waitcnt vmcnt(4)
    buffer_load_dwordx4 v[12:15], v0, s[12:15], s39 offen nt
    buffer_load_dwordx4 v[16:19], v0, s[16:19], s39 offen nt
    v_lshlrev_b32 v28, 16, v24
    v_and_b32 v29, s10, v24
    v_lshlrev_b32 v30, 16, v25
    v_and_b32 v31, s10, v25
    v_lshlrev_b32 v32, 16, v26
    v_and_b32 v33, s10, v26
    v_lshlrev_b32 v34, 16, v27
    v_and_b32 v35, s10, v27
    v_pk_mul_f32 v[28:29], v[28:29], s[8:9]
    v_pk_mul_f32 v[30:31], v[30:31], s[8:9]
    v_pk_mul_f32 v[32:33], v[32:33], s[8:9]
    v_pk_mul_f32 v[34:35], v[34:35], s[8:9]
    v_lshlrev_b32 v36, 16, v20
    v_and_b32 v37, s10, v20
    v_lshlrev_b32 v38, 16, v21
    v_and_b32 v39, s10, v21
    v_lshlrev_b32 v40, 16, v22
    v_and_b32 v41, s10, v22
    v_lshlrev_b32 v42, 16, v23
    v_and_b32 v43, s10, v23
    v_cvt_pk_bf16_f32 v24, v28, v29
    v_cvt_pk_bf16_f32 v25, v30, v31
    v_cvt_pk_bf16_f32 v26, v32, v33
    v_cvt_pk_bf16_f32 v27, v34, v35
    v_lshlrev_b32 v28, 16, v24
    v_and_b32 v29, s10, v24
    v_lshlrev_b32 v30, 16, v25
    v_and_b32 v31, s10, v25
    v_lshlrev_b32 v32, 16, v26
    v_and_b32 v33, s10, v26
    v_lshlrev_b32 v34, 16, v27
    v_and_b32 v35, s10, v27
    v_pk_add_f32 v[36:37], v[36:37], v[28:29]
    v_pk_add_f32 v[38:39], v[38:39], v[30:31]
    v_pk_add_f32 v[40:41], v[40:41], v[32:33]
    v_pk_add_f32 v[42:43], v[42:43], v[34:35]
    v_cvt_pk_bf16_f32 v20, v36, v37
    v_cvt_pk_bf16_f32 v21, v38, v39
    v_cvt_pk_bf16_f32 v22, v40, v41
    v_cvt_pk_bf16_f32 v23, v42, v43
    buffer_store_dwordx4 v[20:23], v0, s[20:23], s37 offen sc1
    s_waitcnt vmcnt(4)
    buffer_load_dwordx4 v[20:23], v0, s[12:15], s40 offen nt
    buffer_load_dwordx4 v[24:27], v0, s[16:19], s40 offen nt
    v_lshlrev_b32 v28, 16, v8
    v_and_b32 v29, s10, v8
    v_lshlrev_b32 v30, 16, v9
    v_and_b32 v31, s10, v9
    v_lshlrev_b32 v32, 16, v10
    v_and_b32 v33, s10, v10
    v_lshlrev_b32 v34, 16, v11
    v_and_b32 v35, s10, v11
    v_pk_mul_f32 v[28:29], v[28:29], s[8:9]
    v_pk_mul_f32 v[30:31], v[30:31], s[8:9]
    v_pk_mul_f32 v[32:33], v[32:33], s[8:9]
    v_pk_mul_f32 v[34:35], v[34:35], s[8:9]
    v_lshlrev_b32 v36, 16, v4
    v_and_b32 v37, s10, v4
    v_lshlrev_b32 v38, 16, v5
    v_and_b32 v39, s10, v5
    v_lshlrev_b32 v40, 16, v6
    v_and_b32 v41, s10, v6
    v_lshlrev_b32 v42, 16, v7
    v_and_b32 v43, s10, v7
    v_cvt_pk_bf16_f32 v8, v28, v29
    v_cvt_pk_bf16_f32 v9, v30, v31
    v_cvt_pk_bf16_f32 v10, v32, v33
    v_cvt_pk_bf16_f32 v11, v34, v35
    v_lshlrev_b32 v28, 16, v8
    v_and_b32 v29, s10, v8
    v_lshlrev_b32 v30, 16, v9
    v_and_b32 v31, s10, v9
    v_lshlrev_b32 v32, 16, v10
    v_and_b32 v33, s10, v10
    v_lshlrev_b32 v34, 16, v11
    v_and_b32 v35, s10, v11
    v_pk_add_f32 v[36:37], v[36:37], v[28:29]
    v_pk_add_f32 v[38:39], v[38:39], v[30:31]
    v_pk_add_f32 v[40:41], v[40:41], v[32:33]
    v_pk_add_f32 v[42:43], v[42:43], v[34:35]
    v_cvt_pk_bf16_f32 v4, v36, v37
    v_cvt_pk_bf16_f32 v5, v38, v39
    v_cvt_pk_bf16_f32 v6, v40, v41
    v_cvt_pk_bf16_f32 v7, v42, v43
    buffer_store_dwordx4 v[4:7], v0, s[20:23], s38 offen sc1
    s_waitcnt vmcnt(4)
    buffer_load_dwordx4 v[4:7], v0, s[12:15], s41 offen nt
    buffer_load_dwordx4 v[8:11], v0, s[16:19], s41 offen nt
    v_lshlrev_b32 v28, 16, v16
    v_and_b32 v29, s10, v16
    v_lshlrev_b32 v30, 16, v17
    v_and_b32 v31, s10, v17
    v_lshlrev_b32 v32, 16, v18
    v_and_b32 v33, s10, v18
    v_lshlrev_b32 v34, 16, v19
    v_and_b32 v35, s10, v19
    v_pk_mul_f32 v[28:29], v[28:29], s[8:9]
    v_pk_mul_f32 v[30:31], v[30:31], s[8:9]
    v_pk_mul_f32 v[32:33], v[32:33], s[8:9]
    v_pk_mul_f32 v[34:35], v[34:35], s[8:9]
    v_lshlrev_b32 v36, 16, v12
    v_and_b32 v37, s10, v12
    v_lshlrev_b32 v38, 16, v13
    v_and_b32 v39, s10, v13
    v_lshlrev_b32 v40, 16, v14
    v_and_b32 v41, s10, v14
    v_lshlrev_b32 v42, 16, v15
    v_and_b32 v43, s10, v15
    v_cvt_pk_bf16_f32 v16, v28, v29
    v_cvt_pk_bf16_f32 v17, v30, v31
    v_cvt_pk_bf16_f32 v18, v32, v33
    v_cvt_pk_bf16_f32 v19, v34, v35
    v_lshlrev_b32 v28, 16, v16
    v_and_b32 v29, s10, v16
    v_lshlrev_b32 v30, 16, v17
    v_and_b32 v31, s10, v17
    v_lshlrev_b32 v32, 16, v18
    v_and_b32 v33, s10, v18
    v_lshlrev_b32 v34, 16, v19
    v_and_b32 v35, s10, v19
    v_pk_add_f32 v[36:37], v[36:37], v[28:29]
    v_pk_add_f32 v[38:39], v[38:39], v[30:31]
    v_pk_add_f32 v[40:41], v[40:41], v[32:33]
    v_pk_add_f32 v[42:43], v[42:43], v[34:35]
    v_cvt_pk_bf16_f32 v12, v36, v37
    v_cvt_pk_bf16_f32 v13, v38, v39
    v_cvt_pk_bf16_f32 v14, v40, v41
    v_cvt_pk_bf16_f32 v15, v42, v43
    buffer_store_dwordx4 v[12:15], v0, s[20:23], s39 offen sc1
    s_waitcnt vmcnt(4)
    v_lshlrev_b32 v28, 16, v24
    v_and_b32 v29, s10, v24
    v_lshlrev_b32 v30, 16, v25
    v_and_b32 v31, s10, v25
    v_lshlrev_b32 v32, 16, v26
    v_and_b32 v33, s10, v26
    v_lshlrev_b32 v34, 16, v27
    v_and_b32 v35, s10, v27
    v_pk_mul_f32 v[28:29], v[28:29], s[8:9]
    v_pk_mul_f32 v[30:31], v[30:31], s[8:9]
    v_pk_mul_f32 v[32:33], v[32:33], s[8:9]
    v_pk_mul_f32 v[34:35], v[34:35], s[8:9]
    v_lshlrev_b32 v36, 16, v20
    v_and_b32 v37, s10, v20
    v_lshlrev_b32 v38, 16, v21
    v_and_b32 v39, s10, v21
    v_lshlrev_b32 v40, 16, v22
    v_and_b32 v41, s10, v22
    v_lshlrev_b32 v42, 16, v23
    v_and_b32 v43, s10, v23
    v_cvt_pk_bf16_f32 v24, v28, v29
    v_cvt_pk_bf16_f32 v25, v30, v31
    v_cvt_pk_bf16_f32 v26, v32, v33
    v_cvt_pk_bf16_f32 v27, v34, v35
    v_lshlrev_b32 v28, 16, v24
    v_and_b32 v29, s10, v24
    v_lshlrev_b32 v30, 16, v25
    v_and_b32 v31, s10, v25
    v_lshlrev_b32 v32, 16, v26
    v_and_b32 v33, s10, v26
    v_lshlrev_b32 v34, 16, v27
    v_and_b32 v35, s10, v27
    v_pk_add_f32 v[36:37], v[36:37], v[28:29]
    v_pk_add_f32 v[38:39], v[38:39], v[30:31]
    v_pk_add_f32 v[40:41], v[40:41], v[32:33]
    v_pk_add_f32 v[42:43], v[42:43], v[34:35]
    v_cvt_pk_bf16_f32 v20, v36, v37
    v_cvt_pk_bf16_f32 v21, v38, v39
    v_cvt_pk_bf16_f32 v22, v40, v41
    v_cvt_pk_bf16_f32 v23, v42, v43
    buffer_store_dwordx4 v[20:23], v0, s[20:23], s40 offen sc1
    s_waitcnt vmcnt(2)
    v_lshlrev_b32 v28, 16, v8
    v_and_b32 v29, s10, v8
    v_lshlrev_b32 v30, 16, v9
    v_and_b32 v31, s10, v9
    v_lshlrev_b32 v32, 16, v10
    v_and_b32 v33, s10, v10
    v_lshlrev_b32 v34, 16, v11
    v_and_b32 v35, s10, v11
    v_pk_mul_f32 v[28:29], v[28:29], s[8:9]
    v_pk_mul_f32 v[30:31], v[30:31], s[8:9]
    v_pk_mul_f32 v[32:33], v[32:33], s[8:9]
    v_pk_mul_f32 v[34:35], v[34:35], s[8:9]
    v_lshlrev_b32 v36, 16, v4
    v_and_b32 v37, s10, v4
    v_lshlrev_b32 v38, 16, v5
    v_and_b32 v39, s10, v5
    v_lshlrev_b32 v40, 16, v6
    v_and_b32 v41, s10, v6
    v_lshlrev_b32 v42, 16, v7
    v_and_b32 v43, s10, v7
    v_cvt_pk_bf16_f32 v8, v28, v29
    v_cvt_pk_bf16_f32 v9, v30, v31
    v_cvt_pk_bf16_f32 v10, v32, v33
    v_cvt_pk_bf16_f32 v11, v34, v35
    v_lshlrev_b32 v28, 16, v8
    v_and_b32 v29, s10, v8
    v_lshlrev_b32 v30, 16, v9
    v_and_b32 v31, s10, v9
    v_lshlrev_b32 v32, 16, v10
    v_and_b32 v33, s10, v10
    v_lshlrev_b32 v34, 16, v11
    v_and_b32 v35, s10, v11
    v_pk_add_f32 v[36:37], v[36:37], v[28:29]
    v_pk_add_f32 v[38:39], v[38:39], v[30:31]
    v_pk_add_f32 v[40:41], v[40:41], v[32:33]
    v_pk_add_f32 v[42:43], v[42:43], v[34:35]
    v_cvt_pk_bf16_f32 v4, v36, v37
    v_cvt_pk_bf16_f32 v5, v38, v39
    v_cvt_pk_bf16_f32 v6, v40, v41
    v_cvt_pk_bf16_f32 v7, v42, v43
    buffer_store_dwordx4 v[4:7], v0, s[20:23], s41 offen sc1
L_done:
    s_endpgm
.section .rodata,"a"
.p2align 6
.amdhsa_kernel standalone__rezero__sampling_kernel
  .amdhsa_next_free_vgpr 44
  .amdhsa_next_free_sgpr 48
  .amdhsa_accum_offset 44
  .amdhsa_group_segment_fixed_size 0
  .amdhsa_kernarg_size 48
  .amdhsa_user_sgpr_count 2
  .amdhsa_user_sgpr_kernarg_segment_ptr 1
  .amdhsa_system_sgpr_workgroup_id_x 1
  .amdhsa_float_denorm_mode_32 3
  .amdhsa_float_denorm_mode_16_64 3
.end_amdhsa_kernel
```
